```python
import torch

def _softmax(x, axis=-1):
    return torch.softmax(x, dim=axis)
def _gelu(x):
    return torch.nn.functional.gelu(x, approximate="tanh")
def _silu(x):
    return torch.nn.functional.silu(x)
def _sigmoid(x):
    return torch.sigmoid(x)
def _layernorm(x, axis=-1, eps=1e-5):
    m = x.mean(dim=axis, keepdim=True)
    v = x.var(dim=axis, keepdim=True, unbiased=False)
    return (x - m) / torch.sqrt(v + eps)
def _scatter_add(tgt, idx, src, axis=0):
    return tgt.clone().index_add_(axis, idx, src)
def _segment_sum(src, seg, n):
    out = torch.zeros((n,) + src.shape[1:], dtype=src.dtype)
    return out.index_add_(0, seg, src)
def _pad(x, pw):
    flat = tuple(v for pair in reversed(pw) for v in pair)
    return torch.nn.functional.pad(x, flat)

kernel_name = 'standalone__linear_kernel_rfa__prompt'

def setup_inputs():

    _w = (lambda a: (lambda t: t.to(torch.bfloat16) if t.is_floating_point() else t)(torch.as_tensor(a)))
    B, H, Sq, Sk, D, M = 1, 16, 2048, 2048, 256, 8
    return {
        "q": _w((lambda *s: torch.randn(*s, dtype=torch.bfloat16) * 0.1)(B, H, Sq, D)),
        "k": _w((lambda *s: torch.randn(*s, dtype=torch.bfloat16) * 1.6)(B, H, Sk, D)),
        "v": _w((lambda *s: torch.randn(*s, dtype=torch.bfloat16) * 1.6)(B, H, Sk, D)),
        "omega": _w((lambda *s: torch.randn(*s, dtype=torch.bfloat16) * 1.6)(M, D)),
    }

def reference(q, k, v, omega):
    d = q.shape[-1]
    m = omega.shape[0]
    scale = float(d) ** -0.25
    qs = q * scale
    ks = k * scale
    q_proj = torch.einsum("bhsd,md->bhsm", qs, omega)
    k_proj = torch.einsum("bhsd,md->bhsm", ks, omega)
    q_sq = 0.5 * torch.einsum("bhsd,bhsd->bhs", qs, qs)[..., None]
    k_sq = 0.5 * torch.einsum("bhsd,bhsd->bhs", ks, ks)[..., None]
    inv_sqrt_m = float(m) ** -0.5
    phi_q = torch.exp(q_proj - q_sq) * inv_sqrt_m + 1e-6
    phi_k = torch.exp(k_proj - k_sq) * inv_sqrt_m + 1e-6
    kv = torch.einsum("bhsm,bhsd->bhmd", phi_k, v)
    z  = torch.einsum("bhsm->bhm", phi_k)
    num = torch.einsum("bhqm,bhmd->bhqd", phi_q, kv)
    den = torch.einsum("bhqm,bhm->bhq", phi_q, z)[..., None] + 1e-6
    return num / den
```

```asm
; @launch grid=(256,1,1) block=(640,1,1) lds=143872
.amdgcn_target "amdgcn-amd-amdhsa--gfx950"
.text
.globl standalone__linear_kernel_rfa__prompt_kernel
.p2align 8
.type standalone__linear_kernel_rfa__prompt_kernel,@function
standalone__linear_kernel_rfa__prompt_kernel:
    s_load_dwordx8 s[4:11], s[0:1], 0
    v_readfirstlane_b32 s3, v0
    s_cmpk_ge_u32 s2, 256
    s_cbranch_scc1 L_end
    s_and_b32 s18, s2, 15
    s_lshr_b32 s19, s2, 4
    s_lshl_b32 s49, s18, 20
    s_lshl_b32 s50, s19, 16
    s_or_b32 s48, s49, s50
    v_and_b32 v1, 63, v0
    v_mov_b32 v8, 0
    v_lshlrev_b32 v20, 2, v1
    s_cmp_eq_u32 s3, 0
    s_cbranch_scc1 L_loader
    ds_write_b32 v20, v8
    s_and_b32 s49, s19, 7
    s_add_u32 s49, s49, s3
    s_cmpk_lg_u32 s49, 128
    s_cbranch_scc1 L_nopf
    s_getpc_b64 s[58:59]
L_pc:
    v_lshlrev_b32 v6, 7, v1
    v_min_u32 v4, L_end-L_pc, v6
    global_load_dword v160, v4, s[58:59]
L_nopf:
    s_waitcnt lgkmcnt(0)
    s_barrier
    s_branch L_notloader
L_loader:
    v_lshrrev_b32 v4, 4, v0
    v_and_b32 v4, 2, v4
    v_xor_b32 v4, v4, v0
    v_lshlrev_b32 v16, 4, v4
    s_mov_b32 s22, 0x1000000
    s_mov_b32 s23, 0x20000
    v_xor_b32 v17, 64, v16
    v_xor_b32 v18, 0x80, v16
    v_xor_b32 v19, 0xc0, v16
    s_movk_i32 m0, 512
    s_mov_b32 s52, s48
    s_movk_i32 s68, -4
    s_mov_b32 s72, 65544
    s_mov_b32 s73, 0x10001
    s_waitcnt lgkmcnt(0)
    s_mov_b32 s20, s6
    s_mov_b32 s21, s7
L_ld:
    s_waitcnt vmcnt(19)
    buffer_load_dwordx4 v16, s[20:23], s52 offen offset:0 nt lds
    s_waitcnt vmcnt(19)
    buffer_load_dwordx4 v17, s[20:23], s52 offen offset:1024 nt lds
    s_waitcnt vmcnt(19)
    buffer_load_dwordx4 v18, s[20:23], s52 offen offset:2048 nt lds
    v_mov_b32 v10, s68
    s_cmp_lt_i32 s68, 1
    s_waitcnt vmcnt(19)
    s_cbranch_scc1 L_ld_noprog
    ds_write_b32 v20, v10 offset:12
L_ld_noprog:
    buffer_load_dwordx4 v19, s[20:23], s52 offen offset:3072 nt lds
    s_add_u32 s49, s68, 5
    s_add_u32 s52, s52, 4096
    s_add_u32 m0, m0, 4096
    s_add_u32 s68, s68, 1
    s_bitcmp1_b64 s[72:73], s49
    s_cbranch_scc0 L_ld
    s_cmp_eq_u32 s49, 16
    s_cbranch_scc1 L_ld_toV
    s_cmp_eq_u32 s49, 32
    s_cbranch_scc1 L_ld_toQ
    s_cmp_eq_u32 s49, 48
    s_cbranch_scc1 L_ld_drain
    s_setprio 2
    s_mov_b32 s44, s10
    s_mov_b32 s45, s11
    s_mov_b32 s46, 4096
    s_mov_b32 s47, 0x20000
    s_mov_b32 s50, m0
    s_mov_b32 m0, 131584
    s_nop 0
    buffer_load_dwordx4 v16, s[44:47], 0 offen offset:0 lds
    buffer_load_dwordx4 v17, s[44:47], 0 offen offset:1024 lds
    buffer_load_dwordx4 v18, s[44:47], 0 offen offset:2048 lds
    buffer_load_dwordx4 v19, s[44:47], 0 offen offset:3072 lds
    s_mov_b32 m0, s50
    s_barrier
    s_branch L_ld
L_ld_toV:
    s_mov_b32 s20, s8
    s_mov_b32 s21, s9
    s_mov_b32 s52, s48
    s_branch L_ld
L_ld_toQ:
    s_mov_b32 s20, s4
    s_mov_b32 s21, s5
    s_mov_b32 s52, s48
    s_movk_i32 m0, 512
    s_mov_b32 s53, 0
L_wf1:
    ds_read_b32 v10, v8 offset:0
    s_add_u32 s53, s53, 1
    s_bitcmp1_b32 s53, 23
    s_cbranch_scc1 L_wf1_x
    s_waitcnt lgkmcnt(0)
    v_cmp_gt_i32 vcc, 8, v10
    s_cbranch_vccnz L_wf1
L_wf1_x:
    s_branch L_ld
L_ld_drain:
    v_mov_b32 v10, 44
    s_waitcnt vmcnt(16)
    ds_max_i32 v20, v10 offset:12
    v_mov_b32 v10, 46
    s_waitcnt vmcnt(8)
    ds_max_i32 v20, v10 offset:12
    v_mov_b32 v10, 48
    s_waitcnt vmcnt(0)
    ds_max_i32 v20, v10 offset:12
    s_endpgm
L_notloader:
    s_load_dwordx2 s[12:13], s[0:1], 32
    s_load_dwordx2 s[16:17], s[0:1], 48
    s_lshr_b32 s3, s3, 6
    s_cmp_eq_u32 s3, 1
    s_cbranch_scc1 L_helper
    v_and_b32 v2, 15, v0
    v_bfe_u32 v3, v0, 4, 2
    s_mov_b32 s34, 65536
    s_mov_b32 s35, 0x20000
    s_sub_u32 s3, s3, 2
    s_lshl_b32 s69, s3, 1
    s_add_u32 s69, s69, 2
    v_and_b32 v5, 7, v2
    v_lshlrev_b32 v4, 1, v5
    v_xor_b32 v4, v3, v4
    v_lshlrev_b32 v4, 4, v4
    v_lshl_add_u32 v6, v2, 9, v4
    s_lshl_b32 s49, s3, 13
    v_add_u32 v6, 512, v6
    v_add_u32 v16, s49, v6
    v_xor_b32 v17, 64, v16
    v_xor_b32 v18, 0x80, v16
    v_xor_b32 v19, 0xc0, v16
    v_lshl_add_u32 v4, v5, 9, v4
    v_add_u32 v30, 131584, v4
    v_xor_b32 v31, 64, v30
    v_xor_b32 v32, 0x80, v30
    v_xor_b32 v33, 0xc0, v30
    v_lshlrev_b32 v4, 11, v3
    v_lshl_add_u32 v4, v2, 4, v4
    v_add_u32 v58, s49, v4
    v_lshlrev_b32 v4, 2, v3
    v_sub_u32 v4, v2, v4
    v_mov_b32 v5, 0xffff
    v_mov_b32 v6, 0xffff0000
    v_cmp_eq_u32 vcc, 0, v4
    v_cmp_eq_u32 s[58:59], 1, v4
    s_nop 0
    v_cndmask_b32 v21, 0, v5, vcc
    v_cmp_eq_u32 vcc, 2, v4
    v_cndmask_b32 v21, v21, v6, s[58:59]
    v_cmp_eq_u32 s[58:59], 3, v4
    v_cndmask_b32 v22, 0, v5, vcc
    v_and_b32 v34, 0x3e803e80, v21
    v_cndmask_b32 v22, v22, v6, s[58:59]
    v_and_b32 v35, 0x3e803e80, v22
    v_lshrrev_b32 v4, 2, v1
    v_and_b32 v5, 7, v4
    s_lshl_b32 s49, s3, 1
    v_xor_b32 v5, s49, v5
    v_lshlrev_b32 v5, 5, v5
    v_lshl_add_u32 v23, v4, 9, v5
    v_and_b32 v5, 3, v1
    v_lshl_add_u32 v23, v5, 3, v23
    v_add_u32 v23, 66048, v23
    v_xor_b32 v24, 32, v23
    v_lshlrev_b32 v4, 4, v1
    v_add_u32 v25, 135680, v4
    s_and_b32 s50, s19, 7
    s_lshl_b32 s50, s50, 3
    s_add_u32 s50, s50, s3
    s_lshl_b32 s50, s50, 10
    v_add_u32 v20, s50, v4
    v_and_b32 v59, 1, v3
    v_lshlrev_b32 v59, 3, v59
    v_add_u32 v59, 384, v59
    v_cmp_gt_u32 s[58:59], 32, v1
    s_lshr_b32 s49, s3, 1
    s_lshl_b32 s49, s49, 10
    s_and_b32 s50, s3, 1
    s_lshl_b32 s50, s50, 3
    s_add_u32 s49, s49, s50
    v_add_u32 v6, s49, v25
    s_waitcnt lgkmcnt(0)
    s_add_u32 s32, s12, s48
    s_addc_u32 s33, s13, 0
    s_mov_b32 s53, 0
L_wf2:
    ds_read_b32 v13, v8 offset:12
    s_add_u32 s53, s53, 1
    s_bitcmp1_b32 s53, 23
    s_cbranch_scc1 L_wf2_x
    s_waitcnt lgkmcnt(0)
    v_cmp_gt_i32 vcc, 4, v13
    s_cbranch_vccnz L_wf2
L_wf2_x:
    ds_read_b128 v[64:67], v30 offset:0
    ds_read_b128 v[68:71], v31 offset:0
    ds_read_b128 v[72:75], v32 offset:0
    ds_read_b128 v[76:79], v33 offset:0
    ds_read_b128 v[80:83], v30 offset:256
    ds_read_b128 v[84:87], v31 offset:256
    ds_read_b128 v[88:91], v32 offset:256
    ds_read_b128 v[92:95], v33 offset:256
    v_and_b32 v4, 1, v3
    v_lshlrev_b32 v4, 11, v4
    v_lshl_add_u32 v4, v2, 6, v4
    v_lshrrev_b32 v5, 2, v2
    v_lshl_add_u32 v4, v5, 4, v4
    v_add_u32 v30, 139776, v4
    v_xor_b32 v31, 16, v30
    v_xor_b32 v32, 32, v30
    v_xor_b32 v33, 48, v30
    v_mov_b32 v5, 1
    s_mov_b32 s53, 0
L_wf3:
    ds_read_b32 v13, v8 offset:12
    s_add_u32 s53, s53, 1
    s_bitcmp1_b32 s53, 23
    s_cbranch_scc1 L_wf3_x
    s_waitcnt lgkmcnt(0)
    v_cmp_gt_i32 vcc, s69, v13
    s_cbranch_vccnz L_wf3
L_wf3_x:
    ds_read_b128 v[96:99], v16 offset:0
    ds_read_b128 v[100:103], v17 offset:0
    ds_read_b128 v[104:107], v18 offset:0
    ds_read_b128 v[108:111], v19 offset:0
    ds_read_b128 v[112:115], v16 offset:256
    ds_read_b128 v[116:119], v17 offset:256
    ds_read_b128 v[120:123], v18 offset:256
    ds_read_b128 v[124:127], v19 offset:256
    v_mov_b32 v40, 0xbd00bd00
    v_mov_b32 v41, 0xbd00bd00
    s_waitcnt lgkmcnt(7)
    v_mfma_f32_16x16x32_bf16 v[46:49], v[96:99], v[96:99], 0
    v_mfma_f32_16x16x32_bf16 v[42:45], v[96:99], v[64:67], 0
    s_waitcnt lgkmcnt(6)
    v_mfma_f32_16x16x32_bf16 v[46:49], v[100:103], v[100:103], v[46:49]
    v_mfma_f32_16x16x32_bf16 v[42:45], v[100:103], v[68:71], v[42:45]
    s_waitcnt lgkmcnt(5)
    v_mfma_f32_16x16x32_bf16 v[46:49], v[104:107], v[104:107], v[46:49]
    v_mfma_f32_16x16x32_bf16 v[42:45], v[104:107], v[72:75], v[42:45]
    s_waitcnt lgkmcnt(4)
    v_mfma_f32_16x16x32_bf16 v[46:49], v[108:111], v[108:111], v[46:49]
    v_mfma_f32_16x16x32_bf16 v[42:45], v[108:111], v[76:79], v[42:45]
    s_waitcnt lgkmcnt(3)
    v_mfma_f32_16x16x32_bf16 v[46:49], v[112:115], v[112:115], v[46:49]
    v_mfma_f32_16x16x32_bf16 v[42:45], v[112:115], v[80:83], v[42:45]
    s_waitcnt lgkmcnt(2)
    v_mfma_f32_16x16x32_bf16 v[46:49], v[116:119], v[116:119], v[46:49]
    v_mfma_f32_16x16x32_bf16 v[42:45], v[116:119], v[84:87], v[42:45]
    s_waitcnt lgkmcnt(1)
    v_mfma_f32_16x16x32_bf16 v[46:49], v[120:123], v[120:123], v[46:49]
    v_mfma_f32_16x16x32_bf16 v[42:45], v[120:123], v[88:91], v[42:45]
    s_waitcnt lgkmcnt(0)
    v_mfma_f32_16x16x32_bf16 v[46:49], v[124:127], v[124:127], v[46:49]
    v_mfma_f32_16x16x32_bf16 v[42:45], v[124:127], v[92:95], v[42:45]
    s_nop 6
    v_cvt_pk_bf16_f32 v36, v46, v47
    v_cvt_pk_bf16_f32 v37, v48, v49
    v_and_b32 v36, v36, v21
    v_and_b32 v37, v37, v22
    v_cvt_pk_bf16_f32 v38, v42, v43
    v_cvt_pk_bf16_f32 v39, v44, v45
    s_nop 1
    v_mfma_f32_16x16x32_bf16 v[50:53], v[34:37], v[38:41], 0
    s_nop 7
    v_cvt_pk_bf16_f32 v50, 0, v50
    v_cvt_pk_bf16_f32 v51, 0, v51
    v_cvt_pk_bf16_f32 v52, 0, v52
    v_cvt_pk_bf16_f32 v53, 0, v53
    v_mul_f32 v50, 0x3fb8aa3b, v50
    v_mul_f32 v51, 0x3fb8aa3b, v51
    v_mul_f32 v52, 0x3fb8aa3b, v52
    v_mul_f32 v53, 0x3fb8aa3b, v53
    v_exp_f32 v50, v50
    v_exp_f32 v51, v51
    v_exp_f32 v52, v52
    v_exp_f32 v53, v53
    v_cvt_pk_bf16_f32 v50, 0, v50
    v_cvt_pk_bf16_f32 v51, 0, v51
    v_cvt_pk_bf16_f32 v52, 0, v52
    v_cvt_pk_bf16_f32 v53, 0, v53
    v_mul_f32 v50, 0x3eb504f3, v50
    v_mul_f32 v51, 0x3eb504f3, v51
    v_mul_f32 v52, 0x3eb504f3, v52
    v_mul_f32 v53, 0x3eb504f3, v53
    v_cvt_pk_bf16_f32 v50, 0, v50
    v_cvt_pk_bf16_f32 v51, 0, v51
    v_cvt_pk_bf16_f32 v52, 0, v52
    v_cvt_pk_bf16_f32 v53, 0, v53
    v_add_f32 v50, 0x358637bd, v50
    v_add_f32 v51, 0x358637bd, v51
    v_add_f32 v52, 0x358637bd, v52
    v_add_f32 v53, 0x358637bd, v53
    v_cvt_pk_bf16_f32 v26, v50, v51
    v_cvt_pk_bf16_f32 v27, v52, v53
    ds_write_b64 v6, v[26:27]
    s_mov_b64 exec, 1
    ds_add_u32 v8, v5 offset:0
    s_mov_b64 exec, -1
    s_add_u32 s69, s69, 32
    s_mov_b32 s53, 0
L_wf4:
    ds_read_b128 v[10:13], v8
    s_add_u32 s53, s53, 1
    s_bitcmp1_b32 s53, 23
    s_cbranch_scc1 L_wf4_x
    s_waitcnt lgkmcnt(0)
    v_cmp_gt_i32 vcc, 28, v13
    s_cbranch_vccnz L_wf4
    v_cmp_gt_i32 vcc, 8, v10
    s_cbranch_vccnz L_wf4
    v_cmp_gt_i32 vcc, 1, v11
    s_cbranch_vccnz L_wf4
L_wf4_x:
    v_readfirstlane_b32 s54, v11
    s_waitcnt vmcnt(0)
    ds_read_b128 v[128:131], v25 offset:0
    ds_read_b128 v[132:135], v25 offset:1024
    ds_read_b128 v[136:139], v25 offset:2048
    ds_read_b128 v[140:143], v25 offset:3072
    ds_read_b64_tr_b16 v[96:97], v23 offset:0
    ds_read_b64_tr_b16 v[98:99], v23 offset:8192
    ds_read_b64_tr_b16 v[100:101], v24 offset:0
    ds_read_b64_tr_b16 v[102:103], v24 offset:8192
    ds_read_b64_tr_b16 v[104:105], v23 offset:16384
    ds_read_b64_tr_b16 v[106:107], v23 offset:24576
    ds_read_b64_tr_b16 v[108:109], v24 offset:16384
    ds_read_b64_tr_b16 v[110:111], v24 offset:24576
    s_waitcnt lgkmcnt(4)
    v_mfma_f32_16x16x32_bf16 v[42:45], v[128:131], v[96:99], 0
    v_mfma_f32_16x16x32_bf16 v[46:49], v[128:131], v[100:103], 0
    ds_read_b64_tr_b16 v[112:113], v23 offset:32768
    ds_read_b64_tr_b16 v[114:115], v23 offset:40960
    ds_read_b64_tr_b16 v[116:117], v24 offset:32768
    ds_read_b64_tr_b16 v[118:119], v24 offset:40960
    s_waitcnt lgkmcnt(4)
    v_mfma_f32_16x16x32_bf16 v[42:45], v[132:135], v[104:107], v[42:45]
    v_mfma_f32_16x16x32_bf16 v[46:49], v[132:135], v[108:111], v[46:49]
    s_waitcnt lgkmcnt(0)
    v_mfma_f32_16x16x32_bf16 v[42:45], v[136:139], v[112:115], v[42:45]
    v_mfma_f32_16x16x32_bf16 v[46:49], v[136:139], v[116:119], v[46:49]
    s_mov_b32 s53, 0
L_wf5:
    ds_read_b32 v13, v8 offset:12
    s_add_u32 s53, s53, 1
    s_bitcmp1_b32 s53, 23
    s_cbranch_scc1 L_wf5_x
    s_waitcnt lgkmcnt(0)
    v_cmp_gt_i32 vcc, 32, v13
    s_cbranch_vccnz L_wf5
L_wf5_x:
    ds_read_b64_tr_b16 v[120:121], v23 offset:49152
    ds_read_b64_tr_b16 v[122:123], v23 offset:57344
    ds_read_b64_tr_b16 v[124:125], v24 offset:49152
    ds_read_b64_tr_b16 v[126:127], v24 offset:57344
    s_waitcnt lgkmcnt(2)
    v_mfma_f32_16x16x32_bf16 v[42:45], v[140:143], v[120:123], v[42:45]
    s_waitcnt lgkmcnt(0)
    v_mfma_f32_16x16x32_bf16 v[46:49], v[140:143], v[124:127], v[46:49]
    s_nop 7
    v_cndmask_b32 v50, v46, v42, s[58:59]
    v_cndmask_b32 v51, v47, v43, s[58:59]
    v_cndmask_b32 v52, v48, v44, s[58:59]
    v_cndmask_b32 v53, v49, v45, s[58:59]
    v_min_u32 v50, -2, v50
    v_min_u32 v51, -2, v51
    v_min_u32 v52, -2, v52
    v_min_u32 v53, -2, v53
    s_cmp_eq_u32 s54, 1
    s_cbranch_scc0 L_st6_s
    buffer_store_dwordx4 v[50:53], v20, s[32:35], 0 offen
    s_branch L_st6_d
L_st6_s:
    buffer_store_dwordx4 v[50:53], v20, s[32:35], 0 offen sc1
L_st6_d:
    s_mov_b32 s53, 0
L_wf7:
    ds_read_b32 v13, v8 offset:12
    s_add_u32 s53, s53, 1
    s_bitcmp1_b32 s53, 23
    s_cbranch_scc1 L_wf7_x
    s_waitcnt lgkmcnt(0)
    v_cmp_gt_i32 vcc, s69, v13
    s_cbranch_vccnz L_wf7
L_wf7_x:
    ds_read_b128 v[96:99], v16 offset:0
    ds_read_b128 v[100:103], v17 offset:0
    ds_read_b128 v[104:107], v18 offset:0
    ds_read_b128 v[108:111], v19 offset:0
    ds_read_b128 v[112:115], v16 offset:256
    ds_read_b128 v[116:119], v17 offset:256
    ds_read_b128 v[120:123], v18 offset:256
    ds_read_b128 v[124:127], v19 offset:256
    v_mov_b32 v36, 0xbd00bd00
    v_mov_b32 v37, 0xbd00bd00
    s_waitcnt lgkmcnt(7)
    v_mfma_f32_16x16x32_bf16 v[46:49], v[96:99], v[96:99], 0
    v_mfma_f32_16x16x32_bf16 v[42:45], v[64:67], v[96:99], 0
    s_waitcnt lgkmcnt(6)
    v_mfma_f32_16x16x32_bf16 v[46:49], v[100:103], v[100:103], v[46:49]
    v_mfma_f32_16x16x32_bf16 v[42:45], v[68:71], v[100:103], v[42:45]
    s_waitcnt lgkmcnt(5)
    v_mfma_f32_16x16x32_bf16 v[46:49], v[104:107], v[104:107], v[46:49]
    v_mfma_f32_16x16x32_bf16 v[42:45], v[72:75], v[104:107], v[42:45]
    s_waitcnt lgkmcnt(4)
    v_mfma_f32_16x16x32_bf16 v[46:49], v[108:111], v[108:111], v[46:49]
    v_mfma_f32_16x16x32_bf16 v[42:45], v[76:79], v[108:111], v[42:45]
    s_waitcnt lgkmcnt(3)
    v_mfma_f32_16x16x32_bf16 v[46:49], v[112:115], v[112:115], v[46:49]
    v_mfma_f32_16x16x32_bf16 v[42:45], v[80:83], v[112:115], v[42:45]
    s_waitcnt lgkmcnt(2)
    v_mfma_f32_16x16x32_bf16 v[46:49], v[116:119], v[116:119], v[46:49]
    v_mfma_f32_16x16x32_bf16 v[42:45], v[84:87], v[116:119], v[42:45]
    s_waitcnt lgkmcnt(1)
    v_mfma_f32_16x16x32_bf16 v[46:49], v[120:123], v[120:123], v[46:49]
    v_mfma_f32_16x16x32_bf16 v[42:45], v[88:91], v[120:123], v[42:45]
    s_waitcnt lgkmcnt(0)
    v_mfma_f32_16x16x32_bf16 v[46:49], v[124:127], v[124:127], v[46:49]
    v_mfma_f32_16x16x32_bf16 v[42:45], v[92:95], v[124:127], v[42:45]
    s_nop 6
    v_cvt_pk_bf16_f32 v40, v46, v47
    v_cvt_pk_bf16_f32 v41, v48, v49
    v_and_b32 v40, v40, v21
    v_and_b32 v41, v41, v22
    v_cvt_pk_bf16_f32 v38, v42, v43
    v_cvt_pk_bf16_f32 v39, v44, v45
    s_nop 1
    v_mfma_f32_16x16x32_bf16 v[50:53], v[34:37], v[38:41], 0
    s_nop 7
    v_cvt_pk_bf16_f32 v50, 0, v50
    v_cvt_pk_bf16_f32 v51, 0, v51
    v_cvt_pk_bf16_f32 v52, 0, v52
    v_cvt_pk_bf16_f32 v53, 0, v53
    v_mul_f32 v50, 0x3fb8aa3b, v50
    v_mul_f32 v51, 0x3fb8aa3b, v51
    v_mul_f32 v52, 0x3fb8aa3b, v52
    v_mul_f32 v53, 0x3fb8aa3b, v53
    v_exp_f32 v50, v50
    v_exp_f32 v51, v51
    v_exp_f32 v52, v52
    v_exp_f32 v53, v53
    v_cvt_pk_bf16_f32 v50, 0, v50
    v_cvt_pk_bf16_f32 v51, 0, v51
    v_cvt_pk_bf16_f32 v52, 0, v52
    v_cvt_pk_bf16_f32 v53, 0, v53
    v_mul_f32 v50, 0x3eb504f3, v50
    v_mul_f32 v51, 0x3eb504f3, v51
    v_mul_f32 v52, 0x3eb504f3, v52
    v_mul_f32 v53, 0x3eb504f3, v53
    v_cvt_pk_bf16_f32 v50, 0, v50
    v_cvt_pk_bf16_f32 v51, 0, v51
    v_cvt_pk_bf16_f32 v52, 0, v52
    v_cvt_pk_bf16_f32 v53, 0, v53
    v_add_f32 v50, 0x358637bd, v50
    v_add_f32 v51, 0x358637bd, v51
    v_add_f32 v52, 0x358637bd, v52
    v_add_f32 v53, 0x358637bd, v53
    v_cvt_pk_bf16_f32 v26, v50, v51
    v_cvt_pk_bf16_f32 v27, v52, v53
    v_cndmask_b32 v26, 0, v26, s[58:59]
    v_cndmask_b32 v27, 0, v27, s[58:59]
    s_mov_b32 s53, 0
L_wf8:
    ds_read_b32 v12, v8 offset:8
    s_add_u32 s53, s53, 1
    s_bitcmp1_b32 s53, 23
    s_cbranch_scc1 L_wf8_x
    s_waitcnt lgkmcnt(0)
    v_cmp_gt_i32 vcc, 1, v12
    s_cbranch_vccnz L_wf8
L_wf8_x:
    ds_read_b64 v[28:29], v59
    s_waitcnt lgkmcnt(0)
    v_mfma_f32_16x16x16_bf16 v[50:53], v[26:27], v[28:29], 0
    s_nop 7
    v_cvt_pk_bf16_f32 v54, 0, v50
    v_cvt_pk_bf16_f32 v55, 0, v51
    v_cvt_pk_bf16_f32 v56, 0, v52
    v_cvt_pk_bf16_f32 v57, 0, v53
    v_add_f32 v54, 0x358637bd, v54
    v_add_f32 v55, 0x358637bd, v55
    v_add_f32 v56, 0x358637bd, v56
    v_add_f32 v57, 0x358637bd, v57
    v_cvt_pk_bf16_f32 v54, 0, v54
    v_cvt_pk_bf16_f32 v55, 0, v55
    v_cvt_pk_bf16_f32 v56, 0, v56
    v_cvt_pk_bf16_f32 v57, 0, v57
    v_rcp_f32 v54, v54
    v_rcp_f32 v55, v55
    v_rcp_f32 v56, v56
    v_rcp_f32 v57, v57
    s_mov_b32 s53, 0
L_wf9:
    ds_read_b32 v12, v8 offset:8
    s_add_u32 s53, s53, 1
    s_bitcmp1_b32 s53, 23
    s_cbranch_scc1 L_wf9_x
    s_waitcnt lgkmcnt(0)
    v_cmp_gt_i32 vcc, 3, v12
    s_cbranch_vccnz L_wf9
L_wf9_x:
    ds_read_b128 v[128:131], v30 offset:0
    ds_read_b128 v[132:135], v31 offset:0
    ds_read_b128 v[136:139], v32 offset:0
    ds_read_b128 v[140:143], v33 offset:0
    ds_read_b128 v[144:147], v30 offset:1024
    ds_read_b128 v[148:151], v31 offset:1024
    ds_read_b128 v[152:155], v32 offset:1024
    ds_read_b128 v[156:159], v33 offset:1024
    s_waitcnt lgkmcnt(7)
    v_mfma_f32_16x16x16_bf16 v[64:67], v[26:27], v[128:129], 0
    v_mfma_f32_16x16x16_bf16 v[68:71], v[26:27], v[130:131], 0
    s_waitcnt lgkmcnt(6)
    v_mfma_f32_16x16x16_bf16 v[72:75], v[26:27], v[132:133], 0
    v_mfma_f32_16x16x16_bf16 v[76:79], v[26:27], v[134:135], 0
    s_nop 3
    v_cvt_pk_bf16_f32 v64, 0, v64
    v_cvt_pk_bf16_f32 v65, 0, v65
    v_pk_mul_f32 v[64:65], v[64:65], v[54:55]
    s_waitcnt lgkmcnt(5)
    v_mfma_f32_16x16x16_bf16 v[80:83], v[26:27], v[136:137], 0
    v_cvt_pk_bf16_f32 v68, 0, v68
    v_cvt_pk_bf16_f32 v69, 0, v69
    v_pk_mul_f32 v[68:69], v[68:69], v[54:55]
    v_mfma_f32_16x16x16_bf16 v[84:87], v[26:27], v[138:139], 0
    v_cvt_pk_bf16_f32 v72, 0, v72
    v_cvt_pk_bf16_f32 v73, 0, v73
    v_pk_mul_f32 v[72:73], v[72:73], v[54:55]
    s_waitcnt lgkmcnt(4)
    v_mfma_f32_16x16x16_bf16 v[88:91], v[26:27], v[140:141], 0
    v_cvt_pk_bf16_f32 v76, 0, v76
    v_cvt_pk_bf16_f32 v77, 0, v77
    v_pk_mul_f32 v[76:77], v[76:77], v[54:55]
    v_mfma_f32_16x16x16_bf16 v[92:95], v[26:27], v[142:143], 0
    v_cvt_pk_bf16_f32 v80, 0, v80
    v_cvt_pk_bf16_f32 v81, 0, v81
    v_pk_mul_f32 v[80:81], v[80:81], v[54:55]
    s_waitcnt lgkmcnt(3)
    v_mfma_f32_16x16x16_bf16 v[96:99], v[26:27], v[144:145], 0
    v_cvt_pk_bf16_f32 v84, 0, v84
    v_cvt_pk_bf16_f32 v85, 0, v85
    v_pk_mul_f32 v[84:85], v[84:85], v[54:55]
    v_mfma_f32_16x16x16_bf16 v[100:103], v[26:27], v[146:147], 0
    v_cvt_pk_bf16_f32 v88, 0, v88
    v_cvt_pk_bf16_f32 v89, 0, v89
    v_pk_mul_f32 v[88:89], v[88:89], v[54:55]
    s_waitcnt lgkmcnt(2)
    v_mfma_f32_16x16x16_bf16 v[104:107], v[26:27], v[148:149], 0
    v_cvt_pk_bf16_f32 v92, 0, v92
    v_cvt_pk_bf16_f32 v93, 0, v93
    v_pk_mul_f32 v[92:93], v[92:93], v[54:55]
    v_cvt_pk_bf16_f32 v160, v64, v68
    v_cvt_pk_bf16_f32 v161, v72, v76
    v_cvt_pk_bf16_f32 v162, v80, v84
    v_cvt_pk_bf16_f32 v163, v88, v92
    buffer_store_dwordx4 v[160:163], v58, s[32:35], 0 offen offset:0 nt
    v_cvt_pk_bf16_f32 v164, v65, v69
    v_cvt_pk_bf16_f32 v165, v73, v77
    v_cvt_pk_bf16_f32 v166, v81, v85
    v_cvt_pk_bf16_f32 v167, v89, v93
    buffer_store_dwordx4 v[164:167], v58, s[32:35], 0 offen offset:512 nt
    v_cvt_pk_bf16_f32 v66, 0, v66
    v_cvt_pk_bf16_f32 v67, 0, v67
    v_pk_mul_f32 v[66:67], v[66:67], v[56:57]
    v_mfma_f32_16x16x16_bf16 v[108:111], v[26:27], v[150:151], 0
    v_cvt_pk_bf16_f32 v70, 0, v70
    v_cvt_pk_bf16_f32 v71, 0, v71
    v_pk_mul_f32 v[70:71], v[70:71], v[56:57]
    s_waitcnt lgkmcnt(1)
    v_mfma_f32_16x16x16_bf16 v[112:115], v[26:27], v[152:153], 0
    v_cvt_pk_bf16_f32 v74, 0, v74
    v_cvt_pk_bf16_f32 v75, 0, v75
    v_pk_mul_f32 v[74:75], v[74:75], v[56:57]
    v_mfma_f32_16x16x16_bf16 v[116:119], v[26:27], v[154:155], 0
    v_cvt_pk_bf16_f32 v78, 0, v78
    v_cvt_pk_bf16_f32 v79, 0, v79
    v_pk_mul_f32 v[78:79], v[78:79], v[56:57]
    s_waitcnt lgkmcnt(0)
    v_mfma_f32_16x16x16_bf16 v[120:123], v[26:27], v[156:157], 0
    v_cvt_pk_bf16_f32 v82, 0, v82
    v_cvt_pk_bf16_f32 v83, 0, v83
    v_pk_mul_f32 v[82:83], v[82:83], v[56:57]
    v_mfma_f32_16x16x16_bf16 v[124:127], v[26:27], v[158:159], 0
    v_cvt_pk_bf16_f32 v86, 0, v86
    v_cvt_pk_bf16_f32 v87, 0, v87
    v_pk_mul_f32 v[86:87], v[86:87], v[56:57]
    v_cvt_pk_bf16_f32 v90, 0, v90
    v_cvt_pk_bf16_f32 v91, 0, v91
    v_pk_mul_f32 v[90:91], v[90:91], v[56:57]
    v_cvt_pk_bf16_f32 v94, 0, v94
    v_cvt_pk_bf16_f32 v95, 0, v95
    v_pk_mul_f32 v[94:95], v[94:95], v[56:57]
    v_cvt_pk_bf16_f32 v160, v66, v70
    v_cvt_pk_bf16_f32 v161, v74, v78
    v_cvt_pk_bf16_f32 v162, v82, v86
    v_cvt_pk_bf16_f32 v163, v90, v94
    buffer_store_dwordx4 v[160:163], v58, s[32:35], 0 offen offset:1024 nt
    v_cvt_pk_bf16_f32 v164, v67, v71
    v_cvt_pk_bf16_f32 v165, v75, v79
    v_cvt_pk_bf16_f32 v166, v83, v87
    v_cvt_pk_bf16_f32 v167, v91, v95
    buffer_store_dwordx4 v[164:167], v58, s[32:35], 0 offen offset:1536 nt
    v_cvt_pk_bf16_f32 v96, 0, v96
    v_cvt_pk_bf16_f32 v97, 0, v97
    v_pk_mul_f32 v[96:97], v[96:97], v[54:55]
    v_cvt_pk_bf16_f32 v100, 0, v100
    v_cvt_pk_bf16_f32 v101, 0, v101
    v_pk_mul_f32 v[100:101], v[100:101], v[54:55]
    v_cvt_pk_bf16_f32 v104, 0, v104
    v_cvt_pk_bf16_f32 v105, 0, v105
    v_pk_mul_f32 v[104:105], v[104:105], v[54:55]
    v_cvt_pk_bf16_f32 v108, 0, v108
    v_cvt_pk_bf16_f32 v109, 0, v109
    v_pk_mul_f32 v[108:109], v[108:109], v[54:55]
    v_cvt_pk_bf16_f32 v112, 0, v112
    v_cvt_pk_bf16_f32 v113, 0, v113
    v_pk_mul_f32 v[112:113], v[112:113], v[54:55]
    v_cvt_pk_bf16_f32 v116, 0, v116
    v_cvt_pk_bf16_f32 v117, 0, v117
    v_pk_mul_f32 v[116:117], v[116:117], v[54:55]
    v_cvt_pk_bf16_f32 v120, 0, v120
    v_cvt_pk_bf16_f32 v121, 0, v121
    v_pk_mul_f32 v[120:121], v[120:121], v[54:55]
    v_cvt_pk_bf16_f32 v124, 0, v124
    v_cvt_pk_bf16_f32 v125, 0, v125
    v_pk_mul_f32 v[124:125], v[124:125], v[54:55]
    v_cvt_pk_bf16_f32 v160, v96, v100
    v_cvt_pk_bf16_f32 v161, v104, v108
    v_cvt_pk_bf16_f32 v162, v112, v116
    v_cvt_pk_bf16_f32 v163, v120, v124
    buffer_store_dwordx4 v[160:163], v58, s[32:35], 0 offen offset:256 nt
    v_cvt_pk_bf16_f32 v164, v97, v101
    v_cvt_pk_bf16_f32 v165, v105, v109
    v_cvt_pk_bf16_f32 v166, v113, v117
    v_cvt_pk_bf16_f32 v167, v121, v125
    buffer_store_dwordx4 v[164:167], v58, s[32:35], 0 offen offset:768 nt
    v_cvt_pk_bf16_f32 v98, 0, v98
    v_cvt_pk_bf16_f32 v99, 0, v99
    v_pk_mul_f32 v[98:99], v[98:99], v[56:57]
    v_cvt_pk_bf16_f32 v102, 0, v102
    v_cvt_pk_bf16_f32 v103, 0, v103
    v_pk_mul_f32 v[102:103], v[102:103], v[56:57]
    v_cvt_pk_bf16_f32 v106, 0, v106
    v_cvt_pk_bf16_f32 v107, 0, v107
    v_pk_mul_f32 v[106:107], v[106:107], v[56:57]
    v_cvt_pk_bf16_f32 v110, 0, v110
    v_cvt_pk_bf16_f32 v111, 0, v111
    v_pk_mul_f32 v[110:111], v[110:111], v[56:57]
    v_cvt_pk_bf16_f32 v114, 0, v114
    v_cvt_pk_bf16_f32 v115, 0, v115
    v_pk_mul_f32 v[114:115], v[114:115], v[56:57]
    v_cvt_pk_bf16_f32 v118, 0, v118
    v_cvt_pk_bf16_f32 v119, 0, v119
    v_pk_mul_f32 v[118:119], v[118:119], v[56:57]
    v_cvt_pk_bf16_f32 v122, 0, v122
    v_cvt_pk_bf16_f32 v123, 0, v123
    v_pk_mul_f32 v[122:123], v[122:123], v[56:57]
    v_cvt_pk_bf16_f32 v126, 0, v126
    v_cvt_pk_bf16_f32 v127, 0, v127
    v_pk_mul_f32 v[126:127], v[126:127], v[56:57]
    v_cvt_pk_bf16_f32 v160, v98, v102
    v_cvt_pk_bf16_f32 v161, v106, v110
    v_cvt_pk_bf16_f32 v162, v114, v118
    v_cvt_pk_bf16_f32 v163, v122, v126
    buffer_store_dwordx4 v[160:163], v58, s[32:35], 0 offen offset:1280 nt
    v_cvt_pk_bf16_f32 v164, v99, v103
    v_cvt_pk_bf16_f32 v165, v107, v111
    v_cvt_pk_bf16_f32 v166, v115, v119
    v_cvt_pk_bf16_f32 v167, v123, v127
    buffer_store_dwordx4 v[164:167], v58, s[32:35], 0 offen offset:1792 nt
    s_endpgm
L_helper:
    s_setprio 3
    s_mul_i32 s49, s18, 8192
    s_waitcnt lgkmcnt(0)
    s_add_u32 s40, s16, s49
    s_addc_u32 s41, s17, 0
    s_load_dwordx2 s[56:57], s[40:41], 4608
    s_mov_b32 s42, 8192
    s_mov_b32 s43, 0x20000
    s_add_u32 s32, s12, s48
    s_addc_u32 s33, s13, 0
    s_mov_b32 s34, 65536
    s_mov_b32 s35, 0x20000
    s_lshl_b32 s49, s18, 20
    s_add_u32 s36, s12, s49
    s_addc_u32 s37, s13, 0
    s_mov_b32 s38, 0x100000
    s_mov_b32 s39, 0x20000
    s_getreg_b32 s55, hwreg(HW_REG_XCC_ID, 0, 4)
    v_and_b32 v2, 15, v0
    v_bfe_u32 v3, v0, 4, 2
    v_mov_b32 v24, -1
    v_mov_b32 v25, -1
    v_mov_b32 v26, -1
    v_mov_b32 v27, -1
    v_lshlrev_b32 v20, 4, v1
    s_and_b32 s70, s19, 7
    s_add_u32 s50, s70, 1
    s_and_b32 s50, s50, 7
    s_lshl_b32 s50, s50, 13
    s_lshl_b32 s70, s70, 13
    v_add_u32 v48, 4096, v20
    v_and_b32 v4, 0x2f, v1
    v_cmp_eq_u32 vcc, 0, v4
    v_lshlrev_b32 v4, 4, v3
    v_add_u32 v4, s50, v4
    v_mov_b32 v5, 0x7fffff00
    v_cndmask_b32 v21, v5, v4, vcc
    v_lshrrev_b32 v4, 3, v2
    s_lshl_b32 s49, s19, 1
    v_add_u32 v4, s49, v4
    v_bfe_u32 v6, v4, 2, 2
    v_lshlrev_b32 v23, 6, v4
    v_bfe_u32 v4, v2, 1, 2
    v_xor_b32 v4, v4, v6
    v_lshl_add_u32 v23, v4, 4, v23
    v_and_b32 v4, 1, v2
    v_lshl_add_u32 v23, v4, 3, v23
    v_lshl_add_u32 v23, v3, 11, v23
    v_cmp_gt_u32 vcc, 32, v1
    v_lshlrev_b32 v22, 3, v2
    v_lshlrev_b32 v6, 7, v1
    v_cndmask_b32 v23, v5, v23, vcc
    v_mov_b32 v56, v48
    buffer_load_dwordx4 v[64:67], v20, s[32:35], s70 offen offset:0 nt
    buffer_load_dwordx4 v[68:71], v20, s[32:35], s70 offen offset:1024 nt
    buffer_load_dwordx4 v[72:75], v20, s[32:35], s70 offen offset:2048 nt
    buffer_load_dwordx4 v[76:79], v20, s[32:35], s70 offen offset:3072 nt
    buffer_load_dwordx4 v[64:67], v56, s[32:35], s70 offen offset:0 nt
    buffer_load_dwordx4 v[68:71], v56, s[32:35], s70 offen offset:1024 nt
    buffer_load_dwordx4 v[72:75], v56, s[32:35], s70 offen offset:2048 nt
    buffer_load_dwordx4 v[76:79], v56, s[32:35], s70 offen offset:3072 nt
    buffer_load_dword v28, v21, s[32:35], 0 offen nt
    buffer_load_dword v29, v23, s[40:43], 0 offen offset:0 nt
    buffer_store_dwordx4 v[24:27], v20, s[32:35], s70 offen offset:0
    buffer_store_dwordx4 v[24:27], v20, s[32:35], s70 offen offset:1024
    buffer_store_dwordx4 v[24:27], v20, s[32:35], s70 offen offset:2048
    buffer_store_dwordx4 v[24:27], v20, s[32:35], s70 offen offset:3072
    buffer_store_dwordx4 v[24:27], v48, s[32:35], s70 offen offset:0
    buffer_store_dwordx4 v[24:27], v48, s[32:35], s70 offen offset:1024
    buffer_store_dwordx4 v[24:27], v48, s[32:35], s70 offen offset:2048
    buffer_store_dwordx4 v[24:27], v48, s[32:35], s70 offen offset:3072
    buffer_store_dwordx4 v[24:27], v21, s[32:35], 0 offen
    buffer_store_dwordx2 v[24:25], v23, s[40:43], 0 offen offset:0
    s_waitcnt lgkmcnt(0)
    s_and_b32 s56, s56, -16
    s_mul_i32 s57, s57, 0x4c957f2d
    s_mul_i32 s49, s56, 0x5851f42d
    s_add_u32 s57, s57, s49
    s_mul_hi_u32 s49, s56, 0x4c957f2d
    s_add_u32 s57, s57, s49
    s_mul_i32 s56, s56, 0x4c957f2d
    s_add_u32 s56, s56, 0x767814f0
    s_addc_u32 s57, s57, 0x4057b7ef
    s_or_b32 s49, s56, s55
    v_mov_b32 v52, s49
    v_mov_b32 v53, s57
    s_lshl_b32 s49, s19, 3
    s_add_u32 s49, s49, 4096
    v_mov_b32 v4, 0
    s_waitcnt vmcnt(0)
    s_mov_b64 exec, 1
    buffer_store_dwordx2 v[52:53], v4, s[40:43], s49 offen sc1
    s_mov_b64 exec, -1
    v_lshrrev_b32 v5, 5, v1
    v_mul_u32_u24 v16, 73728, v5
    v_and_b32 v5, 31, v1
    v_lshl_add_u32 v16, v5, 4, v16
    s_lshl_b32 s49, s19, 9
    v_add_u32 v16, s49, v16
    v_and_b32 v5, 1, v3
    v_lshlrev_b32 v18, 3, v5
    v_add_u32 v18, 384, v18
    v_lshlrev_b32 v5, 4, v5
    v_lshl_add_u32 v17, v2, 16, v5
    v_and_b32 v5, 7, v2
    v_add_u32 v5, 1, v5
    v_and_b32 v5, 7, v5
    v_lshl_add_u32 v17, v5, 13, v17
    v_add_u32 v19, 139776, v20
    s_mov_b32 s53, 0
L_wf10:
    ds_read_b32 v13, v8 offset:12
    s_add_u32 s53, s53, 1
    s_bitcmp1_b32 s53, 23
    s_cbranch_scc1 L_wf10_x
    s_waitcnt lgkmcnt(0)
    v_cmp_gt_i32 vcc, 12, v13
    s_cbranch_vccnz L_wf10
L_wf10_x:
    s_mov_b32 s53, 0
    s_mov_b32 s49, 4096
L_rdy1:
    buffer_load_dwordx2 v[64:65], v22, s[40:43], s49 offen sc1
    s_add_u32 s53, s53, 1
    s_waitcnt vmcnt(0)
    v_and_b32 v66, 15, v64
    v_and_b32 v64, -16, v64
    v_cmp_ne_u64 vcc, s[56:57], v[64:65]
    s_bitcmp1_b32 s53, 18
    s_cbranch_scc1 L_rdy1_done
    s_cbranch_vccnz L_rdy1
L_rdy1_done:
    v_cmp_ne_u32 vcc, s55, v66
    s_mov_b32 s54, 1
    s_cbranch_vccz L_mode_done
    s_mov_b32 s54, 2
    buffer_store_dwordx4 v[24:27], v20, s[32:35], s70 offen offset:0 sc1
    buffer_store_dwordx4 v[24:27], v20, s[32:35], s70 offen offset:1024 sc1
    buffer_store_dwordx4 v[24:27], v20, s[32:35], s70 offen offset:2048 sc1
    buffer_store_dwordx4 v[24:27], v20, s[32:35], s70 offen offset:3072 sc1
    buffer_store_dwordx4 v[24:27], v48, s[32:35], s70 offen offset:0 sc1
    buffer_store_dwordx4 v[24:27], v48, s[32:35], s70 offen offset:1024 sc1
    buffer_store_dwordx4 v[24:27], v48, s[32:35], s70 offen offset:2048 sc1
    buffer_store_dwordx4 v[24:27], v48, s[32:35], s70 offen offset:3072 sc1
    buffer_store_dwordx4 v[24:27], v21, s[32:35], 0 offen sc1
    buffer_store_dwordx2 v[24:25], v23, s[40:43], 0 offen offset:0 sc1
    s_lshl_b32 s49, s19, 3
    s_add_u32 s49, s49, 4352
    v_mov_b32 v4, 0
    s_waitcnt vmcnt(0)
    s_mov_b64 exec, 1
    buffer_store_dwordx2 v[52:53], v4, s[40:43], s49 offen sc1
    s_mov_b64 exec, -1
    s_mov_b32 s53, 0
    s_mov_b32 s49, 4352
L_rdy2:
    buffer_load_dwordx2 v[64:65], v22, s[40:43], s49 offen sc1
    s_add_u32 s53, s53, 1
    s_waitcnt vmcnt(0)
    v_and_b32 v66, 15, v64
    v_and_b32 v64, -16, v64
    v_cmp_ne_u64 vcc, s[56:57], v[64:65]
    s_bitcmp1_b32 s53, 18
    s_cbranch_scc1 L_rdy2_done
    s_cbranch_vccnz L_rdy2
L_rdy2_done:
L_mode_done:
    v_mov_b32 v5, s54
    s_mov_b64 exec, 1
    ds_write_b32 v8, v5 offset:4
    s_mov_b64 exec, -1
    v_add_u32 v4, 135680, v20
    v_mov_b32 v24, 0x3f803f80
    v_mov_b32 v25, 0x3f803f80
    v_mov_b32 v26, 0x3f803f80
    v_mov_b32 v27, 0x3f803f80
    s_mov_b32 s53, 0
L_wf11:
    ds_read_b32 v10, v8 offset:0
    s_add_u32 s53, s53, 1
    s_bitcmp1_b32 s53, 23
    s_cbranch_scc1 L_wf11_x
    s_waitcnt lgkmcnt(0)
    v_cmp_gt_i32 vcc, 8, v10
    s_cbranch_vccnz L_wf11
L_wf11_x:
    ds_read_b128 v[28:31], v4 offset:0
    ds_read_b128 v[32:35], v4 offset:1024
    ds_read_b128 v[36:39], v4 offset:2048
    ds_read_b128 v[40:43], v4 offset:3072
    s_waitcnt lgkmcnt(3)
    v_mfma_f32_16x16x32_bf16 v[44:47], v[28:31], v[24:27], 0
    s_waitcnt lgkmcnt(2)
    v_mfma_f32_16x16x32_bf16 v[44:47], v[32:35], v[24:27], v[44:47]
    s_waitcnt lgkmcnt(1)
    v_mfma_f32_16x16x32_bf16 v[44:47], v[36:39], v[24:27], v[44:47]
    s_waitcnt lgkmcnt(0)
    v_mfma_f32_16x16x32_bf16 v[44:47], v[40:43], v[24:27], v[44:47]
    s_nop 7
    v_min_u32 v44, -2, v44
    v_min_u32 v45, -2, v45
    v_min_u32 v46, -2, v46
    v_min_u32 v47, -2, v47
    s_cmp_eq_u32 s54, 1
    s_cbranch_scc0 L_st12_s
    buffer_store_dwordx4 v[44:47], v21, s[32:35], 0 offen
    s_branch L_st12_d
L_st12_s:
    buffer_store_dwordx4 v[44:47], v21, s[32:35], 0 offen sc1
L_st12_d:
    s_mov_b32 s53, 0
L_wf13:
    ds_read_b32 v13, v8 offset:12
    s_add_u32 s53, s53, 1
    s_bitcmp1_b32 s53, 23
    s_cbranch_scc1 L_wf13_x
    s_waitcnt lgkmcnt(0)
    v_cmp_gt_i32 vcc, 32, v13
    s_cbranch_vccnz L_wf13
L_wf13_x:
    s_mov_b32 s53, 0
L_zg:
    buffer_load_dwordx4 v[48:51], v17, s[36:39], 0 offen sc1
    s_add_u32 s53, s53, 1
    s_waitcnt vmcnt(0)
    v_max3_u32 v4, v48, v49, v50
    v_max_u32 v4, v4, v51
    v_cmp_eq_u32 vcc, -1, v4
    s_bitcmp1_b32 s53, 18
    s_cbranch_scc1 L_zg_done
    s_cbranch_vccnz L_zg
L_zg_done:
    s_mov_b32 s49, 0
    buffer_load_dwordx4 v[64:67], v16, s[36:39], s49 offen sc1
    s_mov_b32 s49, 147456
    buffer_load_dwordx4 v[68:71], v16, s[36:39], s49 offen sc1
    s_mov_b32 s49, 294912
    buffer_load_dwordx4 v[72:75], v16, s[36:39], s49 offen sc1
    s_mov_b32 s49, 442368
    buffer_load_dwordx4 v[76:79], v16, s[36:39], s49 offen sc1
    s_mov_b32 s49, 524288
    buffer_load_dwordx4 v[80:83], v16, s[36:39], s49 offen sc1
    s_mov_b32 s49, 671744
    buffer_load_dwordx4 v[84:87], v16, s[36:39], s49 offen sc1
    s_mov_b32 s49, 819200
    buffer_load_dwordx4 v[88:91], v16, s[36:39], s49 offen sc1
    s_mov_b32 s49, 966656
    buffer_load_dwordx4 v[92:95], v16, s[36:39], s49 offen sc1
    v_add_f32_dpp v48, v48, v48 row_ror:8 row_mask:0xf bank_mask:0xf
    v_add_f32_dpp v49, v49, v49 row_ror:8 row_mask:0xf bank_mask:0xf
    v_add_f32_dpp v50, v50, v50 row_ror:8 row_mask:0xf bank_mask:0xf
    v_add_f32_dpp v51, v51, v51 row_ror:8 row_mask:0xf bank_mask:0xf
    v_add_f32_dpp v48, v48, v48 row_ror:4 row_mask:0xf bank_mask:0xf
    v_add_f32_dpp v49, v49, v49 row_ror:4 row_mask:0xf bank_mask:0xf
    v_add_f32_dpp v50, v50, v50 row_ror:4 row_mask:0xf bank_mask:0xf
    v_add_f32_dpp v51, v51, v51 row_ror:4 row_mask:0xf bank_mask:0xf
    v_add_f32_dpp v48, v48, v48 row_ror:2 row_mask:0xf bank_mask:0xf
    v_add_f32_dpp v49, v49, v49 row_ror:2 row_mask:0xf bank_mask:0xf
    v_add_f32_dpp v50, v50, v50 row_ror:2 row_mask:0xf bank_mask:0xf
    v_add_f32_dpp v51, v51, v51 row_ror:2 row_mask:0xf bank_mask:0xf
    v_add_f32_dpp v48, v48, v48 row_ror:1 row_mask:0xf bank_mask:0xf
    v_add_f32_dpp v49, v49, v49 row_ror:1 row_mask:0xf bank_mask:0xf
    v_add_f32_dpp v50, v50, v50 row_ror:1 row_mask:0xf bank_mask:0xf
    v_add_f32_dpp v51, v51, v51 row_ror:1 row_mask:0xf bank_mask:0xf
    v_cvt_pk_bf16_f32 v48, v48, v49
    v_cvt_pk_bf16_f32 v49, v50, v51
    v_mov_b32 v5, 1
    s_mov_b64 exec, 0x10001
    ds_write_b64 v18, v[48:49]
    ds_write_b32 v8, v5 offset:8
    s_mov_b64 exec, -1
    s_mov_b32 s53, 0
    s_branch L_h1_check
L_h1:
    s_mov_b32 s49, 0
    buffer_load_dwordx4 v[64:67], v16, s[36:39], s49 offen sc1
    s_mov_b32 s49, 147456
    buffer_load_dwordx4 v[68:71], v16, s[36:39], s49 offen sc1
    s_mov_b32 s49, 294912
    buffer_load_dwordx4 v[72:75], v16, s[36:39], s49 offen sc1
    s_mov_b32 s49, 442368
    buffer_load_dwordx4 v[76:79], v16, s[36:39], s49 offen sc1
    s_mov_b32 s49, 524288
    buffer_load_dwordx4 v[80:83], v16, s[36:39], s49 offen sc1
    s_mov_b32 s49, 671744
    buffer_load_dwordx4 v[84:87], v16, s[36:39], s49 offen sc1
    s_mov_b32 s49, 819200
    buffer_load_dwordx4 v[88:91], v16, s[36:39], s49 offen sc1
    s_mov_b32 s49, 966656
    buffer_load_dwordx4 v[92:95], v16, s[36:39], s49 offen sc1
L_h1_check:
    s_add_u32 s53, s53, 1
    s_waitcnt vmcnt(7)
    v_max3_u32 v4, v64, v65, v66
    v_max_u32 v4, v4, v67
    s_waitcnt vmcnt(6)
    v_max3_u32 v4, v4, v68, v69
    v_max3_u32 v4, v4, v70, v71
    v_pk_add_f32 v[64:65], v[64:65], v[68:69]
    v_pk_add_f32 v[66:67], v[66:67], v[70:71]
    s_waitcnt vmcnt(5)
    v_max3_u32 v4, v4, v72, v73
    v_max3_u32 v4, v4, v74, v75
    v_pk_add_f32 v[64:65], v[64:65], v[72:73]
    v_pk_add_f32 v[66:67], v[66:67], v[74:75]
    s_waitcnt vmcnt(4)
    v_max3_u32 v4, v4, v76, v77
    v_max3_u32 v4, v4, v78, v79
    v_pk_add_f32 v[64:65], v[64:65], v[76:77]
    v_pk_add_f32 v[66:67], v[66:67], v[78:79]
    s_waitcnt vmcnt(3)
    v_max3_u32 v4, v4, v80, v81
    v_max3_u32 v4, v4, v82, v83
    v_pk_add_f32 v[64:65], v[64:65], v[80:81]
    v_pk_add_f32 v[66:67], v[66:67], v[82:83]
    s_waitcnt vmcnt(2)
    v_max3_u32 v4, v4, v84, v85
    v_max3_u32 v4, v4, v86, v87
    v_pk_add_f32 v[64:65], v[64:65], v[84:85]
    v_pk_add_f32 v[66:67], v[66:67], v[86:87]
    s_waitcnt vmcnt(1)
    v_max3_u32 v4, v4, v88, v89
    v_max3_u32 v4, v4, v90, v91
    v_pk_add_f32 v[64:65], v[64:65], v[88:89]
    v_pk_add_f32 v[66:67], v[66:67], v[90:91]
    s_waitcnt vmcnt(0)
    v_max3_u32 v4, v4, v92, v93
    v_max3_u32 v4, v4, v94, v95
    v_pk_add_f32 v[64:65], v[64:65], v[92:93]
    v_pk_add_f32 v[66:67], v[66:67], v[94:95]
    v_cmp_eq_u32 vcc, -1, v4
    v_mov_b32 v44, v64
    v_mov_b32 v45, v65
    v_mov_b32 v46, v66
    v_mov_b32 v47, v67
    s_bitcmp1_b32 s53, 18
    s_cbranch_scc1 L_h1_done
    s_cbranch_vccnz L_h1
L_h1_done:
    v_permlane32_swap_b32 v64, v44
    v_permlane32_swap_b32 v65, v45
    v_permlane32_swap_b32 v66, v46
    v_permlane32_swap_b32 v67, v47
    v_pk_add_f32 v[64:65], v[64:65], v[44:45]
    v_pk_add_f32 v[66:67], v[66:67], v[46:47]
    v_cvt_pk_bf16_f32 v72, v64, v65
    v_cvt_pk_bf16_f32 v73, v66, v67
    v_min_u32 v72, -2, v72
    v_min_u32 v73, -2, v73
    s_cmp_eq_u32 s54, 1
    s_cbranch_scc0 L_st14_s
    buffer_store_dwordx2 v[72:73], v23, s[40:43], 0 offen offset:0
    s_branch L_st14_d
L_st14_s:
    buffer_store_dwordx2 v[72:73], v23, s[40:43], 0 offen offset:0 sc1
L_st14_d:
    s_mov_b32 s53, 0
    v_mov_b32 v5, 3
    s_waitcnt vmcnt(0)
L_h2:
    buffer_load_dwordx4 v[80:83], v20, s[40:43], 0 offen offset:0 sc1
    buffer_load_dwordx4 v[84:87], v20, s[40:43], 0 offen offset:1024 sc1
    buffer_load_dwordx4 v[88:91], v20, s[40:43], 0 offen offset:2048 sc1
    buffer_load_dwordx4 v[92:95], v20, s[40:43], 0 offen offset:3072 sc1
    s_add_u32 s53, s53, 1
    s_waitcnt vmcnt(3)
    v_max3_u32 v4, v80, v81, v82
    v_max_u32 v4, v4, v83
    s_waitcnt vmcnt(2)
    v_max3_u32 v4, v4, v84, v85
    v_max3_u32 v4, v4, v86, v87
    s_waitcnt vmcnt(1)
    v_max3_u32 v4, v4, v88, v89
    v_max3_u32 v4, v4, v90, v91
    s_waitcnt vmcnt(0)
    v_max3_u32 v4, v4, v92, v93
    v_max3_u32 v4, v4, v94, v95
    v_cmp_eq_u32 vcc, -1, v4
    s_bitcmp1_b32 s53, 18
    s_cbranch_scc1 L_h2_done
    s_cbranch_vccnz L_h2
L_h2_done:
    ds_write_b128 v19, v[80:83] offset:0
    ds_write_b128 v19, v[84:87] offset:1024
    ds_write_b128 v19, v[88:91] offset:2048
    ds_write_b128 v19, v[92:95] offset:3072
    s_mov_b64 exec, 1
    ds_write_b32 v8, v5 offset:8
    s_mov_b64 exec, -1
    s_cmp_lg_u32 s19, 0
    s_cbranch_scc1 L_fin
    v_mov_b32 v4, 0
    s_mov_b32 s49, 4608
    s_mov_b64 exec, 1
    buffer_store_dwordx2 v[52:53], v4, s[40:43], s49 offen
    s_mov_b64 exec, -1
L_fin:
L_end:
    s_endpgm
.section .rodata,"a"
.p2align 6
.amdhsa_kernel standalone__linear_kernel_rfa__prompt_kernel
  .amdhsa_next_free_vgpr 168
  .amdhsa_next_free_sgpr 80
  .amdhsa_accum_offset 168
  .amdhsa_group_segment_fixed_size 0
  .amdhsa_kernarg_size 56
  .amdhsa_user_sgpr_count 2
  .amdhsa_user_sgpr_kernarg_segment_ptr 1
  .amdhsa_system_sgpr_workgroup_id_x 1
  .amdhsa_float_denorm_mode_32 3
.end_amdhsa_kernel
```
